```python
import torch

def _softmax(x, axis=-1):
    return torch.softmax(x, dim=axis)
def _gelu(x):
    return torch.nn.functional.gelu(x, approximate="tanh")
def _silu(x):
    return torch.nn.functional.silu(x)
def _sigmoid(x):
    return torch.sigmoid(x)
def _layernorm(x, axis=-1, eps=1e-5):
    m = x.mean(dim=axis, keepdim=True)
    v = x.var(dim=axis, keepdim=True, unbiased=False)
    return (x - m) / torch.sqrt(v + eps)
def _scatter_add(tgt, idx, src, axis=0):
    return tgt.clone().index_add_(axis, idx, src)
def _segment_sum(src, seg, n):
    out = torch.zeros((n,) + src.shape[1:], dtype=src.dtype)
    return out.index_add_(0, seg, src)
def _pad(x, pw):
    flat = tuple(v for pair in reversed(pw) for v in pair)
    return torch.nn.functional.pad(x, flat)

kernel_name = 'standalone__sliding_block_cached__decode'

def setup_inputs():

    _w = (lambda a: (lambda t: t.to(torch.bfloat16) if t.is_floating_point() else t)(torch.as_tensor(a)))
    B, Sq, D = 4, 1, 512
    Hq, Hkv, Sk, Dh = 32, 8, 4096, 128
    assert Hq % Hkv == 0, (Hq, Hkv)
    return {
        "x": _w((lambda *s: torch.randn(*s, dtype=torch.bfloat16) * 0.8)(B, Sq, D)),
        "k_cache": _w((lambda *s: torch.randn(*s, dtype=torch.bfloat16) * 0.8)(B, Hkv, Sk, Dh)),
        "v_cache": _w((lambda *s: torch.randn(*s, dtype=torch.bfloat16) * 0.05)(B, Hkv, Sk, Dh)),
        "wq": _w((lambda *s: torch.randn(*s, dtype=torch.bfloat16) * 0.8)(D, Hq * Dh) * (D ** -0.5)),
        "wo": _w((lambda *s: torch.randn(*s, dtype=torch.bfloat16) * 0.05)(Hq * Dh, D) * ((Hq * Dh) ** -0.5)),
    }

def reference(x, k_cache, v_cache, wq, wo):
    B, Sq, D = x.shape
    Hq, Dh = 32, 128
    Hkv, Sk = k_cache.shape[1], k_cache.shape[2]
    W = min(4096, max(256, Sk // 4))
    rep = Hq // Hkv
    q = (lambda x, *d: x.permute(*d))((x @ wq).reshape(B, Sq, Hq, Dh), 0, 2, 1, 3)
    k = (lambda x, n, axis: torch.repeat_interleave(x, n, dim=axis))(k_cache[:, :, Sk - W:, :], rep, axis=1)
    v = (lambda x, n, axis: torch.repeat_interleave(x, n, dim=axis))(v_cache[:, :, Sk - W:, :], rep, axis=1)
    scores = torch.einsum("bhqd,bhkd->bhqk", q, k) * (Dh ** -0.5)
    p = _softmax(scores, axis=-1)
    o = torch.einsum("bhqk,bhkd->bhqd", p, v)
    return (lambda x, *d: x.permute(*d))(o, 0, 2, 1, 3).reshape(B, Sq, Hq * Dh) @ wo
```

```asm
; @launch grid=(256,1,1) block=(320,1,1) lds=116736
.amdgcn_target "amdgcn-amd-amdhsa--gfx950"
.text
.globl standalone__sliding_block_cached__decode_kernel
.p2align 8
.type standalone__sliding_block_cached__decode_kernel,@function
standalone__sliding_block_cached__decode_kernel:
  s_cmp_ge_u32 s2, 256
  s_cbranch_scc1 L_end
  s_load_dwordx16 s[4:19], s[0:1], 0
  v_and_b32 v1, 63, v0
  v_lshrrev_b32 v4, 6, v0
  v_and_b32 v2, 15, v0
  v_readfirstlane_b32 s20, v4
  v_lshrrev_b32 v3, 4, v1
  s_and_b32 s21, s2, 7
  s_lshr_b32 s22, s2, 3
  s_lshr_b32 s23, s22, 3
  s_and_b32 s24, s22, 7
  s_mov_b32 s97, s21
  s_mov_b32 s98, s23
  s_mov_b32 s99, s24
  s_cmp_eq_u32 s20, 4
  s_cbranch_scc1 L_Q
  s_lshl_b32 s27, s23, 3
  s_add_u32 s27, s27, s21
  s_lshl_b32 s27, s27, 12
  s_lshl_b32 s28, s24, 7
  s_add_u32 s27, s27, s28
  s_add_u32 s27, s27, 3072
  s_lshl_b32 s27, s27, 8
  s_lshl_b32 s28, s20, 13
  s_add_u32 s28, s28, s27
  v_xor_b32 v4, v2, v3
  v_lshlrev_b32 v4, 4, v4
  v_lshl_add_u32 v4, v3, 8, v4
  v_add_u32 v16, s28, v4
  v_xor_b32 v17, 64, v16
  v_xor_b32 v18, 128, v16
  v_xor_b32 v19, 192, v16
  v_add_u32 v20, 4096, v16
  v_add_u32 v21, 4096, v17
  v_add_u32 v22, 4096, v18
  v_add_u32 v23, 4096, v19
  s_lshl_b32 s35, s20, 13
  s_add_u32 s35, s35, 16384
  s_lshl_b32 s28, s20, 13
  s_add_u32 s28, s28, s27
  v_lshlrev_b32 v4, 1, v3
  v_xor_b32 v4, v2, v4
  v_lshlrev_b32 v5, 4, v4
  v_lshl_add_u32 v5, v3, 8, v5
  v_add_u32 v24, s28, v5
  v_xor_b32 v25, 128, v24
  v_add_u32 v26, 4096, v24
  v_add_u32 v27, 4096, v25
  s_lshl_b32 s36, s20, 13
  s_add_u32 s36, s36, 49152
  s_mov_b32 s30, s22
  s_add_u32 s29, s30, 0
  s_and_b32 s29, s29, 7
  s_lshl_b32 s72, s29, 10
  s_and_b32 s29, s29, 3
  s_lshl_b32 s29, s29, 6
  s_or_b32 s80, s29, s72
  s_add_u32 s29, s30, 1
  s_and_b32 s29, s29, 7
  s_lshl_b32 s73, s29, 10
  s_and_b32 s29, s29, 3
  s_lshl_b32 s29, s29, 6
  s_or_b32 s81, s29, s73
  s_add_u32 s29, s30, 2
  s_and_b32 s29, s29, 7
  s_lshl_b32 s74, s29, 10
  s_and_b32 s29, s29, 3
  s_lshl_b32 s29, s29, 6
  s_or_b32 s82, s29, s74
  s_add_u32 s29, s30, 3
  s_and_b32 s29, s29, 7
  s_lshl_b32 s75, s29, 10
  s_and_b32 s29, s29, 3
  s_lshl_b32 s29, s29, 6
  s_or_b32 s83, s29, s75
  s_add_u32 s29, s30, 4
  s_and_b32 s29, s29, 7
  s_lshl_b32 s76, s29, 10
  s_and_b32 s29, s29, 3
  s_lshl_b32 s29, s29, 6
  s_or_b32 s84, s29, s76
  s_add_u32 s29, s30, 5
  s_and_b32 s29, s29, 7
  s_lshl_b32 s77, s29, 10
  s_and_b32 s29, s29, 3
  s_lshl_b32 s29, s29, 6
  s_or_b32 s85, s29, s77
  s_add_u32 s29, s30, 6
  s_and_b32 s29, s29, 7
  s_lshl_b32 s78, s29, 10
  s_and_b32 s29, s29, 3
  s_lshl_b32 s29, s29, 6
  s_or_b32 s86, s29, s78
  s_add_u32 s29, s30, 7
  s_and_b32 s29, s29, 7
  s_lshl_b32 s79, s29, 10
  s_and_b32 s29, s29, 3
  s_lshl_b32 s29, s29, 6
  s_or_b32 s87, s29, s79
  s_waitcnt lgkmcnt(0)
  s_load_dword s32, s[18:19], 0
  s_barrier
  s_add_u32 m0, s35, s72
  v_xor_b32 v17, s80, v16
  global_load_lds_dwordx4 v17, s[6:7] nt
  s_add_u32 m0, s35, s73
  v_xor_b32 v17, s81, v16
  global_load_lds_dwordx4 v17, s[6:7] nt
  s_add_u32 m0, s35, s74
  v_xor_b32 v17, s82, v16
  global_load_lds_dwordx4 v17, s[6:7] nt
  s_add_u32 m0, s35, s75
  v_xor_b32 v17, s83, v16
  global_load_lds_dwordx4 v17, s[6:7] nt
  s_add_u32 m0, s35, s76
  v_xor_b32 v17, s84, v16
  global_load_lds_dwordx4 v17, s[6:7] nt
  s_add_u32 m0, s35, s77
  v_xor_b32 v17, s85, v16
  global_load_lds_dwordx4 v17, s[6:7] nt
  s_lshl_b32 s27, s97, 9
  s_lshl_b32 s28, s98, 7
  s_add_u32 s27, s27, s28
  s_lshl_b32 s28, s20, 5
  s_add_u32 s27, s27, s28
  s_lshl_b32 s27, s27, 10
  s_lshl_b32 s28, s99, 7
  s_add_u32 s27, s27, s28
  v_lshrrev_b32 v5, 3, v1
  v_lshlrev_b32 v5, 10, v5
  v_and_b32 v6, 7, v1
  v_bfe_u32 v7, v1, 4, 1
  v_lshlrev_b32 v7, 1, v7
  v_xor_b32 v6, v6, v7
  v_lshl_add_u32 v5, v6, 4, v5
  v_add_u32 v28, s27, v5
  v_xor_b32 v5, 64, v28
  v_add_u32 v29, 8192, v5
  v_add_u32 v30, 16384, v28
  v_add_u32 v31, 24576, v5
  s_lshl_b32 s37, s20, 12
  s_add_u32 s37, s37, 81920
  v_cmp_gt_u32 s[38:39], 4, v2
  v_cmp_gt_u32 s[48:49], 8, v2
  v_and_b32 v4, 4, v2
  v_cmp_ne_u32 s[42:43], 0, v4
  v_xor_b32 v4, v2, v3
  v_lshlrev_b32 v4, 4, v4
  v_lshl_add_u32 v4, v2, 8, v4
  v_add_u32 v32, s35, v4
  v_xor_b32 v33, 64, v32
  v_xor_b32 v34, 128, v32
  v_xor_b32 v35, 192, v32
  v_and_b32 v4, 3, v2
  v_lshrrev_b32 v9, 2, v2
  v_mul_u32_u24 v5, 320, v4
  v_lshl_add_u32 v5, v3, 4, v5
  v_mul_u32_u24 v6, 288, v4
  v_lshrrev_b32 v7, 1, v3
  v_lshl_add_u32 v6, v7, 6, v6
  v_and_b32 v7, 1, v3
  v_lshl_add_u32 v6, v7, 4, v6
  v_add_u32 v37, 103552, v6
  v_mul_u32_u24 v6, 1312, v9
  v_add_u32 v5, v5, v6
  v_add_u32 v36, 98304, v5
  v_mul_u32_u24 v5, 288, v4
  v_lshl_add_u32 v5, v3, 3, v5
  s_lshl_b32 s27, s20, 6
  s_add_u32 s27, s27, 103552
  v_add_u32 v39, s27, v5
  v_lshrrev_b32 v6, 1, v9
  v_lshl_add_u32 v39, v6, 5, v39
  v_and_b32 v6, 1, v9
  v_lshl_add_u32 v39, v6, 2, v39
  v_lshlrev_b32 v5, 4, v4
  v_add_u32 v38, 104704, v5
  s_lshl_b32 s27, s20, 2
  v_add_u32 v51, s27, v38
  v_mov_b32 v52, 104832
  v_bfe_u32 v5, v1, 2, 2
  v_and_b32 v6, 3, v1
  v_lshl_add_u32 v7, v3, 3, v5
  v_and_b32 v8, 1, v3
  v_lshl_or_b32 v10, v8, 2, v5
  s_lshl_b32 s27, s20, 1
  v_xor_b32 v10, s27, v10
  v_lshlrev_b32 v10, 5, v10
  v_lshl_add_u32 v10, v7, 8, v10
  v_lshl_add_u32 v10, v6, 3, v10
  v_lshrrev_b32 v11, 1, v3
  v_lshl_add_u32 v10, v11, 12, v10
  v_add_u32 v40, 49152, v10
  v_xor_b32 v41, 32, v40
  v_lshrrev_b32 v10, 1, v5
  v_lshl_or_b32 v10, v8, 1, v10
  v_xor_b32 v10, s20, v10
  v_lshlrev_b32 v10, 5, v10
  v_lshl_add_u32 v10, v7, 7, v10
  v_lshl_add_u32 v10, v6, 3, v10
  v_add_u32 v42, 81920, v10
  v_and_b32 v5, 1, v9
  v_lshlrev_b32 v5, 6, v5
  v_lshl_add_u32 v5, v3, 4, v5
  v_lshl_add_u32 v5, v4, 9, v5
  s_lshl_b32 s27, s21, 2
  s_add_u32 s27, s27, s23
  s_lshl_b32 s27, s27, 3
  s_add_u32 s27, s27, s24
  s_lshl_b32 s27, s27, 11
  s_lshl_b32 s28, s20, 7
  s_add_u32 s27, s27, s28
  s_add_u32 s27, s27, 1048576
  v_add_u32 v43, s27, v5
  s_lshl_b32 s27, s99, 5
  s_lshl_b32 s28, s97, 2
  s_add_u32 s27, s27, s28
  s_add_u32 s27, s27, s98
  s_lshl_b32 s27, s27, 10
  s_lshl_b32 s28, s20, 8
  s_add_u32 s27, s27, s28
  s_add_u32 s27, s27, 1572864
  v_lshlrev_b32 v5, 6, v4
  v_lshl_add_u32 v5, v3, 4, v5
  v_add_u32 v50, s27, v5
  s_lshl_b32 s27, s97, 2
  s_add_u32 s27, s27, s20
  s_lshl_b32 s27, s27, 14
  s_lshl_b32 s28, s98, 9
  s_add_u32 s27, s27, s28
  s_add_u32 s27, s27, 1048576
  v_lshrrev_b32 v5, 5, v1
  v_and_b32 v6, 31, v1
  v_lshlrev_b32 v7, 11, v5
  v_lshl_add_u32 v7, v6, 4, v7
  v_add_u32 v44, s27, v7
  v_add_u32 v45, 4096, v44
  v_add_u32 v46, 8192, v44
  v_add_u32 v47, 12288, v44
  s_mul_i32 s27, s20, 2368
  s_add_u32 s27, s27, 104976
  v_mul_u32_u24 v7, 288, v5
  v_lshl_add_u32 v7, v6, 3, v7
  v_add_u32 v48, s27, v7
  s_lshl_b32 s27, s20, 5
  s_add_u32 s27, s27, 104848
  v_lshlrev_b32 v7, 4, v5
  v_add_u32 v53, s27, v7
  v_mul_u32_u24 v7, 2368, v4
  v_mul_u32_u24 v8, 288, v9
  v_add_u32 v7, v7, v8
  v_lshl_add_u32 v7, v3, 4, v7
  v_add_u32 v49, 104976, v7
  v_and_b32 v7, 1, v9
  v_lshlrev_b32 v7, 2, v7
  v_lshrrev_b32 v8, 1, v9
  v_add_u32 v7, v7, v8
  v_lshlrev_b32 v7, 2, v7
  v_lshl_add_u32 v7, v4, 5, v7
  v_add_u32 v54, 104848, v7
  s_mov_b32 s33, 0x3e0293ee
  s_lshl_b32 s27, s21, 2
  s_add_u32 s27, s27, s23
  s_lshl_b32 s27, s27, 13
  s_lshl_b32 s28, s20, 11
  s_add_u32 s27, s27, s28
  s_add_u32 s27, s27, 262144
  v_lshlrev_b32 v5, 4, v1
  v_add_u32 v162, s27, v5
  v_lshrrev_b32 v5, 5, v1
  v_mul_u32_u24 v5, 320, v5
  v_and_b32 v6, 31, v1
  v_lshl_add_u32 v5, v6, 3, v5
  s_mul_i32 s27, s20, 1312
  s_add_u32 s27, s27, 98304
  v_add_u32 v163, s27, v5
  s_lshl_b32 s27, s20, 2
  s_add_u32 s27, s27, 104832
  v_mov_b32 v188, s27
  s_getreg_b32 s46, hwreg(HW_REG_XCC_ID, 0, 4)
  s_barrier
  s_add_u32 m0, s35, s78
  v_xor_b32 v17, s86, v16
  global_load_lds_dwordx4 v17, s[6:7] nt
  s_add_u32 m0, s35, s79
  v_xor_b32 v17, s87, v16
  global_load_lds_dwordx4 v17, s[6:7] nt
  s_lshr_b32 s27, s72, 4
  s_and_b32 s27, s27, 0x80
  s_or_b32 s27, s27, s72
  s_add_u32 m0, s36, s72
  v_xor_b32 v25, s27, v24
  global_load_lds_dwordx4 v25, s[8:9] nt
  s_lshr_b32 s27, s73, 4
  s_and_b32 s27, s27, 0x80
  s_or_b32 s27, s27, s73
  s_add_u32 m0, s36, s73
  v_xor_b32 v25, s27, v24
  global_load_lds_dwordx4 v25, s[8:9] nt
  s_lshr_b32 s27, s74, 4
  s_and_b32 s27, s27, 0x80
  s_or_b32 s27, s27, s74
  s_add_u32 m0, s36, s74
  v_xor_b32 v25, s27, v24
  global_load_lds_dwordx4 v25, s[8:9] nt
  s_lshr_b32 s27, s75, 4
  s_and_b32 s27, s27, 0x80
  s_or_b32 s27, s27, s75
  s_add_u32 m0, s36, s75
  v_xor_b32 v25, s27, v24
  global_load_lds_dwordx4 v25, s[8:9] nt
  s_waitcnt vmcnt(4)
  global_load_dwordx4 v[164:167], v162, s[18:19] sc1
  global_load_dwordx4 v[168:171], v162, s[18:19] offset:1024 sc1
  s_lshr_b32 s27, s76, 4
  s_and_b32 s27, s27, 0x80
  s_or_b32 s27, s27, s76
  s_add_u32 m0, s36, s76
  v_xor_b32 v25, s27, v24
  global_load_lds_dwordx4 v25, s[8:9] nt
  s_lshr_b32 s27, s77, 4
  s_and_b32 s27, s27, 0x80
  s_or_b32 s27, s27, s77
  s_add_u32 m0, s36, s77
  v_xor_b32 v25, s27, v24
  global_load_lds_dwordx4 v25, s[8:9] nt
  s_waitcnt vmcnt(4)
  s_lshr_b32 s27, s78, 4
  s_and_b32 s27, s27, 0x80
  s_or_b32 s27, s27, s78
  s_add_u32 m0, s36, s78
  v_xor_b32 v25, s27, v24
  global_load_lds_dwordx4 v25, s[8:9] nt
  s_lshr_b32 s27, s79, 4
  s_and_b32 s27, s27, 0x80
  s_or_b32 s27, s27, s79
  s_add_u32 m0, s36, s79
  v_xor_b32 v25, s27, v24
  global_load_lds_dwordx4 v25, s[8:9] nt
  s_waitcnt lgkmcnt(0)
  s_add_u32 s31, s32, 1
  s_mul_i32 s31, s31, 0x9E3779B1
  s_add_u32 s31, s31, 0x7F4A7C15
  s_waitcnt vmcnt(10)
  ds_read_b128 v[56:59], v32 offset:0
  ds_read_b128 v[60:63], v33 offset:0
  ds_read_b128 v[64:67], v34 offset:0
  ds_read_b128 v[68:71], v35 offset:0
  ds_read_b128 v[72:75], v32 offset:4096
  ds_read_b128 v[76:79], v33 offset:4096
  ds_read_b128 v[80:83], v34 offset:4096
  ds_read_b128 v[84:87], v35 offset:4096
  s_waitcnt vmcnt(4)
  v_cmp_eq_u32 vcc, s31, v166
  v_cmp_eq_u32 s[44:45], s31, v170
  s_and_b64 vcc, vcc, s[44:45]
  s_cmp_eq_u64 vcc, -1
  s_cbranch_scc1 L_g0
  s_mov_b32 s34, 0
L_gp:
  global_load_dwordx4 v[164:167], v162, s[18:19] sc1
  global_load_dwordx4 v[168:171], v162, s[18:19] offset:1024 sc1
  s_waitcnt vmcnt(0)
  v_cmp_eq_u32 vcc, s31, v166
  v_cmp_eq_u32 s[44:45], s31, v170
  s_and_b64 vcc, vcc, s[44:45]
  s_cmp_eq_u64 vcc, -1
  s_cbranch_scc1 L_gpoll
  s_add_u32 s34, s34, 1
  s_cmp_lt_u32 s34, 12
  s_cbranch_scc1 L_gp
  v_xor_b32 v162, 786432, v162
  s_cmp_lt_u32 s34, 200000
  s_cbranch_scc1 L_gp
L_gpoll:
  s_add_u32 s96, s34, 10
  ds_write_b64 v163, v[164:165]
  ds_write_b64 v163, v[168:169] offset:640
  v_cmp_eq_u32 vcc, s46, v167
  v_cmp_eq_u32 s[44:45], s46, v171
  s_branch L_gdone
L_g0:
  s_mov_b32 s96, 0
  ds_write_b64 v163, v[164:165]
  ds_write_b64 v163, v[168:169] offset:640
  v_cmp_eq_u32 vcc, s46, v167
  v_cmp_eq_u32 s[44:45], s46, v171
  s_branch L_gdone
L_gdone:
  s_and_b64 vcc, vcc, s[44:45]
  s_cmp_eq_u64 vcc, -1
  s_cselect_b32 s47, 1, 0
  v_mov_b32 v4, s47
  ds_write_b32 v188, v4
  s_waitcnt lgkmcnt(0)
  s_barrier
  ds_read_b128 v[88:91], v36 offset:0
  ds_read_b128 v[92:95], v36 offset:64
  ds_read_b128 v[96:99], v36 offset:128
  ds_read_b128 v[100:103], v36 offset:192
  s_add_u32 m0, s37, 0
  s_nop 0
  global_load_lds_dwordx4 v28, s[12:13] nt
  s_add_u32 m0, s37, 1024
  s_nop 0
  global_load_lds_dwordx4 v29, s[12:13] nt
  s_add_u32 m0, s37, 2048
  s_nop 0
  global_load_lds_dwordx4 v30, s[12:13] nt
  s_add_u32 m0, s37, 3072
  s_nop 0
  global_load_lds_dwordx4 v31, s[12:13] nt
  s_waitcnt lgkmcnt(3)
  v_mfma_f32_16x16x32_bf16 v[104:107], v[56:59], v[88:91], 0
  v_mfma_f32_16x16x32_bf16 v[108:111], v[72:75], v[88:91], 0
  s_waitcnt lgkmcnt(2)
  v_mfma_f32_16x16x32_bf16 v[104:107], v[60:63], v[92:95], v[104:107]
  v_mfma_f32_16x16x32_bf16 v[108:111], v[76:79], v[92:95], v[108:111]
  s_waitcnt lgkmcnt(1)
  v_mfma_f32_16x16x32_bf16 v[104:107], v[64:67], v[96:99], v[104:107]
  v_mfma_f32_16x16x32_bf16 v[108:111], v[80:83], v[96:99], v[108:111]
  s_waitcnt lgkmcnt(0)
  v_mfma_f32_16x16x32_bf16 v[104:107], v[68:71], v[100:103], v[104:107]
  v_mfma_f32_16x16x32_bf16 v[108:111], v[84:87], v[100:103], v[108:111]
  ds_read_b128 v[12:15], v52
  s_nop 6
  v_add_f32_dpp v152, v104, v104 row_ror:8 row_mask:0xf bank_mask:0x3
  v_add_f32_dpp v153, v105, v105 row_ror:8 row_mask:0xf bank_mask:0x3
  v_add_f32_dpp v154, v106, v106 row_ror:8 row_mask:0xf bank_mask:0x3
  v_add_f32_dpp v155, v107, v107 row_ror:8 row_mask:0xf bank_mask:0x3
  v_add_f32_dpp v152, v108, v108 row_ror:8 row_mask:0xf bank_mask:0xc
  v_add_f32_dpp v153, v109, v109 row_ror:8 row_mask:0xf bank_mask:0xc
  v_add_f32_dpp v154, v110, v110 row_ror:8 row_mask:0xf bank_mask:0xc
  v_add_f32_dpp v155, v111, v111 row_ror:8 row_mask:0xf bank_mask:0xc
  v_add_f32_dpp v104, v152, v152 row_shl:4 row_mask:0xf bank_mask:0x5
  v_add_f32_dpp v105, v153, v153 row_shl:4 row_mask:0xf bank_mask:0x5
  v_add_f32_dpp v104, v154, v154 row_shr:4 row_mask:0xf bank_mask:0xa
  v_add_f32_dpp v105, v155, v155 row_shr:4 row_mask:0xf bank_mask:0xa
  s_waitcnt lgkmcnt(0)
  v_max_f32 v4, v104, v105
  v_and_b32 v12, v12, v13
  v_and_b32 v14, v14, v15
  v_max_f32_dpp v4, v4, v4 row_ror:4 row_mask:0xf bank_mask:0xf
  v_and_b32 v12, v12, v14
  s_nop 0
  v_max_f32_dpp v4, v4, v4 row_ror:8 row_mask:0xf bank_mask:0xf
  v_readfirstlane_b32 s47, v12
  v_mov_b32 v5, v4
  s_nop 1
  v_permlane16_swap_b32 v4, v5
  v_max_f32 v4, v4, v5
  v_mov_b32 v5, v4
  s_nop 1
  v_permlane32_swap_b32 v4, v5
  v_max_f32 v4, v4, v5
  s_mov_b64 exec, s[38:39]
  ds_write_b32 v51, v4
  s_mov_b64 exec, -1
  s_waitcnt lgkmcnt(0)
  s_barrier
  ds_read_b128 v[4:7], v38
  v_mov_b32 v11, s31
  s_waitcnt lgkmcnt(0)
  v_max3_f32 v4, v4, v5, v6
  v_max_f32 v4, v4, v7
  v_mul_f32 v160, s33, v4
  v_fma_f32 v104, v104, s33, -v160
  v_fma_f32 v105, v105, s33, -v160
  v_exp_f32 v104, v104
  v_exp_f32 v105, v105
  s_nop 0
  v_cvt_pk_bf16_f32 v8, v104, v105
  v_add_f32 v4, v104, v105
  ds_write_b32 v39, v8
  s_nop 0
  v_add_f32_dpp v4, v4, v4 row_ror:4 row_mask:0xf bank_mask:0xf
  s_nop 1
  v_add_f32_dpp v4, v4, v4 row_ror:8 row_mask:0xf bank_mask:0xf
  v_mov_b32 v5, v4
  s_nop 1
  v_permlane16_swap_b32 v4, v5
  v_add_f32 v4, v4, v5
  v_mov_b32 v5, v4
  s_nop 1
  v_permlane32_swap_b32 v4, v5
  v_add_f32 v4, v4, v5
  s_mov_b64 exec, s[38:39]
  ds_write_b32 v51, v4 offset:64
  s_mov_b64 exec, -1
  s_waitcnt vmcnt(4) lgkmcnt(0)
  s_barrier
  ds_read_b128 v[4:7], v38 offset:64
  ds_read_b128 v[88:91], v37 offset:0
  ds_read_b64_tr_b16 v[56:57], v40 offset:0
  ds_read_b64_tr_b16 v[58:59], v40 offset:1024
  ds_read_b64_tr_b16 v[60:61], v41 offset:0
  ds_read_b64_tr_b16 v[62:63], v41 offset:1024
  ds_read_b128 v[92:95], v37 offset:128
  ds_read_b64_tr_b16 v[64:65], v40 offset:16384
  ds_read_b64_tr_b16 v[66:67], v40 offset:17408
  ds_read_b64_tr_b16 v[68:69], v41 offset:16384
  ds_read_b64_tr_b16 v[70:71], v41 offset:17408
  s_waitcnt lgkmcnt(10)
  v_add_f32 v4, v4, v5
  v_add_f32 v6, v6, v7
  s_waitcnt lgkmcnt(5)
  v_mfma_f32_16x16x32_bf16 v[112:115], v[56:59], v[88:91], 0
  v_mfma_f32_16x16x32_bf16 v[116:119], v[60:63], v[88:91], 0
  ds_read_b128 v[96:99], v37 offset:32
  ds_read_b64_tr_b16 v[72:73], v40 offset:4096
  ds_read_b64_tr_b16 v[74:75], v40 offset:5120
  ds_read_b64_tr_b16 v[76:77], v41 offset:4096
  ds_read_b64_tr_b16 v[78:79], v41 offset:5120
  v_add_f32 v4, v4, v6
  s_waitcnt lgkmcnt(5)
  v_mfma_f32_16x16x32_bf16 v[112:115], v[64:67], v[92:95], v[112:115]
  v_mfma_f32_16x16x32_bf16 v[116:119], v[68:71], v[92:95], v[116:119]
  ds_read_b128 v[100:103], v37 offset:160
  ds_read_b64_tr_b16 v[80:81], v40 offset:20480
  ds_read_b64_tr_b16 v[82:83], v40 offset:21504
  ds_read_b64_tr_b16 v[84:85], v41 offset:20480
  ds_read_b64_tr_b16 v[86:87], v41 offset:21504
  v_rcp_f32 v161, v4
  v_log_f32 v4, v4
  s_waitcnt lgkmcnt(5)
  v_mfma_f32_16x16x32_bf16 v[112:115], v[72:75], v[96:99], v[112:115]
  v_mfma_f32_16x16x32_bf16 v[116:119], v[76:79], v[96:99], v[116:119]
  v_add_f32 v10, v160, v4
  s_waitcnt lgkmcnt(0)
  v_mfma_f32_16x16x32_bf16 v[112:115], v[80:83], v[100:103], v[112:115]
  v_mfma_f32_16x16x32_bf16 v[116:119], v[84:87], v[100:103], v[116:119]
  s_cmp_lg_u32 s47, 0
  s_nop 6
  v_cndmask_b32 v152, v112, v116, s[42:43]
  v_cndmask_b32 v153, v113, v117, s[42:43]
  v_cndmask_b32 v154, v114, v118, s[42:43]
  v_cndmask_b32 v155, v115, v119, s[42:43]
  v_mul_f32 v152, v152, v161
  v_mul_f32 v153, v153, v161
  v_mul_f32 v154, v154, v161
  v_mul_f32 v155, v155, v161
  v_cvt_pk_bf16_f32 v8, v152, v153
  v_cvt_pk_bf16_f32 v9, v154, v155
  s_mov_b64 exec, s[48:49]
  s_cbranch_scc0 L_oremote
  global_store_dwordx4 v43, v[8:11], s[18:19]
  s_branch L_ostored
L_oremote:
  global_store_dwordx4 v43, v[8:11], s[18:19] sc1
L_ostored:
  s_mov_b64 exec, -1
  s_mov_b32 s34, 200000
  global_load_dwordx4 v[136:139], v44, s[18:19] sc1
  global_load_dwordx4 v[140:143], v45, s[18:19] sc1
  global_load_dwordx4 v[144:147], v46, s[18:19] sc1
  global_load_dwordx4 v[148:151], v47, s[18:19] sc1
  s_waitcnt vmcnt(0)
L_ochk:
  v_cmp_eq_u32 vcc, s31, v139
  v_cmp_eq_u32 s[44:45], s31, v143
  s_and_b64 vcc, vcc, s[44:45]
  v_cmp_eq_u32 s[44:45], s31, v147
  s_and_b64 vcc, vcc, s[44:45]
  v_cmp_eq_u32 s[44:45], s31, v151
  s_and_b64 vcc, vcc, s[44:45]
  s_cmp_eq_u64 vcc, -1
  s_cbranch_scc1 L_ogot
  global_load_dwordx4 v[136:139], v44, s[18:19] sc1
  global_load_dwordx4 v[140:143], v45, s[18:19] sc1
  global_load_dwordx4 v[144:147], v46, s[18:19] sc1
  global_load_dwordx4 v[148:151], v47, s[18:19] sc1
  s_waitcnt vmcnt(0)
  s_sub_u32 s34, s34, 1
  s_cmp_lg_u32 s34, 0
  s_cbranch_scc1 L_ochk
L_ogot:
  ds_write_b64 v48, v[136:137] offset:0
  ds_write_b64 v48, v[140:141] offset:576
  ds_write_b64 v48, v[144:145] offset:1152
  ds_write_b64 v48, v[148:149] offset:1728
  s_mov_b32 exec_lo, 1
  s_mov_b32 exec_hi, 1
  ds_write2_b32 v53, v138, v142 offset0:0 offset1:1
  ds_write2_b32 v53, v146, v150 offset0:2 offset1:3
L_owritten:
  s_mov_b64 exec, -1
  s_waitcnt vmcnt(0) lgkmcnt(0)
  s_barrier
  ds_read_b32 v4, v54
  ds_read_b32 v5, v54 offset:8
  ds_read_b64_tr_b16 v[120:121], v42 offset:0
  ds_read_b64_tr_b16 v[122:123], v42 offset:512
  ds_read_b128 v[56:59], v49 offset:0
  ds_read_b128 v[60:63], v49 offset:1152
  ds_read_b64_tr_b16 v[124:125], v42 offset:4096
  ds_read_b64_tr_b16 v[126:127], v42 offset:4608
  ds_read_b128 v[64:67], v49 offset:64
  ds_read_b128 v[68:71], v49 offset:1216
  ds_read_b64_tr_b16 v[128:129], v42 offset:8192
  ds_read_b64_tr_b16 v[130:131], v42 offset:8704
  ds_read_b128 v[72:75], v49 offset:128
  ds_read_b128 v[76:79], v49 offset:1280
  s_waitcnt lgkmcnt(8)
  v_max_f32 v6, v4, v5
  v_mfma_f32_16x16x32_bf16 v[112:115], v[120:123], v[56:59], 0
  v_mfma_f32_16x16x32_bf16 v[116:119], v[120:123], v[60:63], 0
  ds_read_b64_tr_b16 v[132:133], v42 offset:12288
  ds_read_b64_tr_b16 v[134:135], v42 offset:12800
  ds_read_b128 v[80:83], v49 offset:192
  ds_read_b128 v[84:87], v49 offset:1344
  v_max_f32_dpp v6, v6, v6 row_ror:4 row_mask:0xf bank_mask:0xf
  s_waitcnt lgkmcnt(8)
  v_mfma_f32_16x16x32_bf16 v[112:115], v[124:127], v[64:67], v[112:115]
  v_mfma_f32_16x16x32_bf16 v[116:119], v[124:127], v[68:71], v[116:119]
  v_max_f32_dpp v6, v6, v6 row_ror:8 row_mask:0xf bank_mask:0xf
  v_sub_f32 v4, v4, v6
  v_sub_f32 v5, v5, v6
  v_exp_f32 v4, v4
  v_exp_f32 v5, v5
  s_waitcnt lgkmcnt(4)
  v_mfma_f32_16x16x32_bf16 v[112:115], v[128:131], v[72:75], v[112:115]
  v_mfma_f32_16x16x32_bf16 v[116:119], v[128:131], v[76:79], v[116:119]
  v_add_f32 v6, v4, v5
  s_waitcnt lgkmcnt(0)
  v_mfma_f32_16x16x32_bf16 v[112:115], v[132:135], v[80:83], v[112:115]
  v_mfma_f32_16x16x32_bf16 v[116:119], v[132:135], v[84:87], v[116:119]
  v_add_f32_dpp v6, v6, v6 row_ror:4 row_mask:0xf bank_mask:0xf
  v_mov_b32 v10, s31
  v_mov_b32 v11, s31
  v_add_f32_dpp v6, v6, v6 row_ror:8 row_mask:0xf bank_mask:0xf
  v_rcp_f32 v6, v6
  s_nop 0
  v_mul_f32 v4, v4, v6
  v_mul_f32 v5, v5, v6
  s_nop 0
  v_mul_f32 v152, v112, v4
  v_mul_f32 v153, v113, v4
  v_mul_f32 v154, v114, v4
  v_mul_f32 v155, v115, v4
  v_fmac_f32 v152, v116, v5
  v_fmac_f32 v153, v117, v5
  v_fmac_f32 v154, v118, v5
  v_fmac_f32 v155, v119, v5
  v_add_f32_dpp v152, v152, v152 row_ror:4 row_mask:0xf bank_mask:0xf
  v_add_f32_dpp v153, v153, v153 row_ror:4 row_mask:0xf bank_mask:0xf
  v_add_f32_dpp v154, v154, v154 row_ror:4 row_mask:0xf bank_mask:0xf
  v_add_f32_dpp v155, v155, v155 row_ror:4 row_mask:0xf bank_mask:0xf
  v_add_f32_dpp v152, v152, v152 row_ror:8 row_mask:0xf bank_mask:0xf
  v_add_f32_dpp v153, v153, v153 row_ror:8 row_mask:0xf bank_mask:0xf
  v_add_f32_dpp v154, v154, v154 row_ror:8 row_mask:0xf bank_mask:0xf
  v_add_f32_dpp v155, v155, v155 row_ror:8 row_mask:0xf bank_mask:0xf
  v_cvt_pk_bf16_f32 v8, v152, v153
  v_cvt_pk_bf16_f32 v9, v154, v155
  s_mov_b64 exec, s[38:39]
  global_store_dwordx4 v50, v[8:11], s[18:19] sc1
L_pstored:
  s_mov_b64 exec, -1
  s_waitcnt vmcnt(0)
  s_barrier
  s_branch L_fin
L_Q:
  s_setprio 3
  s_and_b32 s29, s22, 3
  s_lshr_b32 s30, s22, 2
  v_and_b32 v4, 3, v2
  v_lshlrev_b32 v5, 10, v4
  v_lshl_add_u32 v5, v3, 4, v5
  s_lshl_b32 s27, s29, 8
  v_add_u32 v16, s27, v5
  s_lshl_b32 s27, s29, 20
  s_lshl_b32 s28, s21, 10
  s_add_u32 s27, s27, s28
  s_lshl_b32 s28, s30, 7
  s_add_u32 s27, s27, s28
  v_lshrrev_b32 v5, 3, v1
  v_lshlrev_b32 v5, 13, v5
  v_and_b32 v6, 7, v1
  v_bfe_u32 v7, v1, 4, 1
  v_lshlrev_b32 v7, 1, v7
  v_xor_b32 v6, v6, v7
  v_lshl_add_u32 v5, v6, 4, v5
  v_add_u32 v17, s27, v5
  v_xor_b32 v5, 64, v17
  v_add_u32 v18, 65536, v5
  v_add_u32 v19, 131072, v17
  v_add_u32 v20, 196608, v5
  v_add_u32 v21, 262144, v17
  v_add_u32 v22, 327680, v5
  v_add_u32 v23, 393216, v17
  v_add_u32 v24, 458752, v5
  v_add_u32 v25, 524288, v17
  v_add_u32 v26, 589824, v5
  v_add_u32 v27, 655360, v17
  v_add_u32 v28, 720896, v5
  v_add_u32 v29, 786432, v17
  v_add_u32 v30, 851968, v5
  v_add_u32 v31, 917504, v17
  v_add_u32 v32, 983040, v5
  s_waitcnt lgkmcnt(0)
  s_load_dword s32, s[18:19], 0
  global_load_dwordx4 v[48:51], v16, s[4:5] offset:0
  global_load_dwordx4 v[52:55], v16, s[4:5] offset:64
  global_load_dwordx4 v[56:59], v16, s[4:5] offset:128
  global_load_dwordx4 v[60:63], v16, s[4:5] offset:192
  s_mov_b32 m0, 0
  s_nop 0
  global_load_lds_dwordx4 v17, s[10:11] nt
  s_mov_b32 m0, 1024
  s_nop 0
  global_load_lds_dwordx4 v18, s[10:11] nt
  s_mov_b32 m0, 2048
  s_nop 0
  global_load_lds_dwordx4 v19, s[10:11] nt
  s_mov_b32 m0, 3072
  s_nop 0
  global_load_lds_dwordx4 v20, s[10:11] nt
  s_mov_b32 m0, 4096
  s_nop 0
  global_load_lds_dwordx4 v21, s[10:11] nt
  s_mov_b32 m0, 5120
  s_nop 0
  global_load_lds_dwordx4 v22, s[10:11] nt
  s_mov_b32 m0, 6144
  s_nop 0
  global_load_lds_dwordx4 v23, s[10:11] nt
  s_mov_b32 m0, 7168
  s_nop 0
  global_load_lds_dwordx4 v24, s[10:11] nt
  s_mov_b32 m0, 8192
  s_nop 0
  global_load_lds_dwordx4 v25, s[10:11] nt
  s_mov_b32 m0, 9216
  s_nop 0
  global_load_lds_dwordx4 v26, s[10:11] nt
  s_mov_b32 m0, 10240
  s_nop 0
  global_load_lds_dwordx4 v27, s[10:11] nt
  s_mov_b32 m0, 11264
  s_nop 0
  global_load_lds_dwordx4 v28, s[10:11] nt
  s_mov_b32 m0, 12288
  s_nop 0
  global_load_lds_dwordx4 v29, s[10:11] nt
  s_mov_b32 m0, 13312
  s_nop 0
  global_load_lds_dwordx4 v30, s[10:11] nt
  s_mov_b32 m0, 14336
  s_nop 0
  global_load_lds_dwordx4 v31, s[10:11] nt
  s_mov_b32 m0, 15360
  s_nop 0
  global_load_lds_dwordx4 v32, s[10:11] nt
  s_lshl_b32 s27, s21, 15
  s_lshl_b32 s28, s29, 11
  s_add_u32 s27, s27, s28
  s_lshl_b32 s28, s30, 8
  s_add_u32 s27, s27, s28
  s_add_u32 s27, s27, 262144
  v_lshlrev_b32 v5, 13, v4
  v_lshrrev_b32 v6, 2, v2
  v_lshl_add_u32 v5, v6, 6, v5
  v_lshl_add_u32 v5, v3, 4, v5
  v_add_u32 v37, s27, v5
  s_waitcnt vmcnt(16)
  s_barrier
  s_getreg_b32 s46, hwreg(HW_REG_XCC_ID, 0, 4)
  v_and_b32 v5, 8, v2
  v_cmp_ne_u32 s[40:41], 0, v5
  v_and_b32 v5, 4, v2
  v_cmp_ne_u32 s[42:43], 0, v5
  v_bfe_u32 v5, v1, 2, 2
  v_and_b32 v6, 3, v1
  v_lshl_add_u32 v7, v3, 3, v5
  v_lshrrev_b32 v8, 1, v5
  v_and_b32 v9, 1, v3
  v_lshl_or_b32 v8, v9, 1, v8
  v_lshlrev_b32 v8, 5, v8
  v_lshl_add_u32 v8, v7, 7, v8
  v_lshl_add_u32 v8, v6, 3, v8
  v_add_u32 v33, 0, v8
  v_xor_b32 v34, 32, v33
  v_xor_b32 v35, 64, v33
  v_xor_b32 v36, 96, v33
  s_lshl_b32 s27, s21, 2
  s_add_u32 s27, s27, s23
  s_lshl_b32 s27, s27, 13
  s_add_u32 s27, s27, 262144
  v_lshlrev_b32 v5, 4, v1
  v_add_u32 v38, s27, v5
  v_add_u32 v45, 2048, v38
  v_add_u32 v46, 4096, v38
  v_add_u32 v47, 6144, v38
  v_lshrrev_b32 v5, 5, v1
  v_mul_u32_u24 v5, 320, v5
  v_and_b32 v6, 31, v1
  v_lshl_add_u32 v5, v6, 3, v5
  v_add_u32 v39, 98304, v5
  s_lshl_b32 s27, s21, 2
  s_add_u32 s27, s27, s23
  s_and_b32 s28, s27, 7
  s_lshl_b32 s28, s28, 3
  s_add_u32 s28, s28, s24
  s_lshr_b32 s27, s27, 3
  s_lshr_b32 s29, s28, 3
  s_lshl_b32 s29, s29, 15
  s_bfe_u32 s30, s28, 0x20001
  s_lshl_b32 s30, s30, 8
  s_add_u32 s29, s29, s30
  s_lshl_b32 s30, s27, 6
  s_add_u32 s29, s29, s30
  s_and_b32 s30, s28, 1
  s_lshl_b32 s30, s30, 5
  s_add_u32 s29, s29, s30
  s_add_u32 s29, s29, 1572864
  v_lshrrev_b32 v5, 1, v1
  v_lshlrev_b32 v5, 10, v5
  v_and_b32 v6, 1, v1
  v_lshl_add_u32 v5, v6, 4, v5
  v_add_u32 v40, s29, v5
  s_lshl_b32 s27, s27, 10
  s_lshl_b32 s28, s28, 4
  s_add_u32 s27, s27, s28
  v_and_b32 v7, 1, v3
  v_lshlrev_b32 v7, 1, v7
  v_lshrrev_b32 v8, 1, v3
  v_or_b32 v7, v7, v8
  v_lshl_add_u32 v7, v6, 2, v7
  v_lshlrev_b32 v7, 1, v7
  v_add_u32 v44, s27, v7
  v_mov_b32 v11, s46
  s_waitcnt lgkmcnt(0)
  s_add_u32 s31, s32, 1
  s_mul_i32 s31, s31, 0x9E3779B1
  s_add_u32 s31, s31, 0x7F4A7C15
  s_waitcnt vmcnt(12)
  ds_read_b64_tr_b16 v[64:65], v33 offset:0
  ds_read_b64_tr_b16 v[66:67], v33 offset:512
  ds_read_b64_tr_b16 v[68:69], v34 offset:0
  ds_read_b64_tr_b16 v[70:71], v34 offset:512
  ds_read_b64_tr_b16 v[72:73], v35 offset:0
  ds_read_b64_tr_b16 v[74:75], v35 offset:512
  ds_read_b64_tr_b16 v[76:77], v36 offset:0
  ds_read_b64_tr_b16 v[78:79], v36 offset:512
  s_waitcnt vmcnt(8)
  ds_read_b64_tr_b16 v[80:81], v33 offset:4096
  ds_read_b64_tr_b16 v[82:83], v33 offset:4608
  ds_read_b64_tr_b16 v[84:85], v34 offset:4096
  ds_read_b64_tr_b16 v[86:87], v34 offset:4608
  ds_read_b64_tr_b16 v[88:89], v35 offset:4096
  ds_read_b64_tr_b16 v[90:91], v35 offset:4608
  ds_read_b64_tr_b16 v[92:93], v36 offset:4096
  ds_read_b64_tr_b16 v[94:95], v36 offset:4608
  s_waitcnt lgkmcnt(8)
  v_mfma_f32_16x16x32_bf16 v[128:131], v[64:67], v[48:51], 0
  v_mfma_f32_16x16x32_bf16 v[132:135], v[68:71], v[48:51], 0
  v_mfma_f32_16x16x32_bf16 v[136:139], v[72:75], v[48:51], 0
  v_mfma_f32_16x16x32_bf16 v[140:143], v[76:79], v[48:51], 0
  s_waitcnt vmcnt(4)
  ds_read_b64_tr_b16 v[96:97], v33 offset:8192
  ds_read_b64_tr_b16 v[98:99], v33 offset:8704
  ds_read_b64_tr_b16 v[100:101], v34 offset:8192
  ds_read_b64_tr_b16 v[102:103], v34 offset:8704
  ds_read_b64_tr_b16 v[104:105], v35 offset:8192
  ds_read_b64_tr_b16 v[106:107], v35 offset:8704
  ds_read_b64_tr_b16 v[108:109], v36 offset:8192
  ds_read_b64_tr_b16 v[110:111], v36 offset:8704
  s_waitcnt lgkmcnt(8)
  v_mfma_f32_16x16x32_bf16 v[128:131], v[80:83], v[52:55], v[128:131]
  v_mfma_f32_16x16x32_bf16 v[132:135], v[84:87], v[52:55], v[132:135]
  v_mfma_f32_16x16x32_bf16 v[136:139], v[88:91], v[52:55], v[136:139]
  v_mfma_f32_16x16x32_bf16 v[140:143], v[92:95], v[52:55], v[140:143]
  s_waitcnt vmcnt(0)
  ds_read_b64_tr_b16 v[112:113], v33 offset:12288
  ds_read_b64_tr_b16 v[114:115], v33 offset:12800
  ds_read_b64_tr_b16 v[116:117], v34 offset:12288
  ds_read_b64_tr_b16 v[118:119], v34 offset:12800
  ds_read_b64_tr_b16 v[120:121], v35 offset:12288
  ds_read_b64_tr_b16 v[122:123], v35 offset:12800
  ds_read_b64_tr_b16 v[124:125], v36 offset:12288
  ds_read_b64_tr_b16 v[126:127], v36 offset:12800
  s_waitcnt lgkmcnt(8)
  v_mfma_f32_16x16x32_bf16 v[128:131], v[96:99], v[56:59], v[128:131]
  v_mfma_f32_16x16x32_bf16 v[132:135], v[100:103], v[56:59], v[132:135]
  v_mfma_f32_16x16x32_bf16 v[136:139], v[104:107], v[56:59], v[136:139]
  v_mfma_f32_16x16x32_bf16 v[140:143], v[108:111], v[56:59], v[140:143]
  s_waitcnt lgkmcnt(0)
  v_mfma_f32_16x16x32_bf16 v[128:131], v[112:115], v[60:63], v[128:131]
  v_mfma_f32_16x16x32_bf16 v[132:135], v[116:119], v[60:63], v[132:135]
  v_mfma_f32_16x16x32_bf16 v[136:139], v[120:123], v[60:63], v[136:139]
  v_mfma_f32_16x16x32_bf16 v[140:143], v[124:127], v[60:63], v[140:143]
  v_mov_b32 v10, s31
  s_nop 7
  v_cndmask_b32 v128, v128, v132, s[42:43]
  v_cndmask_b32 v136, v136, v140, s[42:43]
  v_cndmask_b32 v129, v129, v133, s[42:43]
  v_cndmask_b32 v137, v137, v141, s[42:43]
  v_cndmask_b32 v130, v130, v134, s[42:43]
  v_cndmask_b32 v138, v138, v142, s[42:43]
  v_cndmask_b32 v131, v131, v135, s[42:43]
  v_cndmask_b32 v139, v139, v143, s[42:43]
  v_cndmask_b32 v128, v128, v136, s[40:41]
  v_cndmask_b32 v129, v129, v137, s[40:41]
  v_cndmask_b32 v130, v130, v138, s[40:41]
  v_cndmask_b32 v131, v131, v139, s[40:41]
  v_cvt_pk_bf16_f32 v8, v128, v129
  v_cvt_pk_bf16_f32 v9, v130, v131
  global_store_dwordx4 v37, v[8:11], s[18:19]
  v_add_u32 v5, 262144, v37
  global_store_dwordx4 v5, v[8:11], s[18:19] sc1
  s_barrier
  s_lshl_b32 s27, s21, 2
  s_add_u32 s27, s27, s23
  s_lshl_b32 s27, s27, 3
  s_add_u32 s27, s27, s24
  s_lshl_b32 s27, s27, 11
  s_add_u32 s27, s27, 1048576
  v_lshlrev_b32 v5, 4, v1
  v_add_u32 v38, s27, v5
  s_lshl_b32 s27, s99, 5
  s_lshl_b32 s28, s97, 2
  s_add_u32 s27, s27, s28
  s_add_u32 s27, s27, s98
  s_lshl_b32 s27, s27, 10
  s_add_u32 s27, s27, 1572864
  v_add_u32 v39, s27, v5
  s_barrier
  global_load_dwordx4 v[152:155], v39, s[18:19] sc1
  s_barrier
  s_barrier
  s_barrier
  s_barrier
  s_setprio 0
  s_mov_b32 s34, 200000
L_fpoll:
  global_load_dwordx4 v[64:67], v40, s[18:19] sc1
  s_waitcnt vmcnt(0)
  v_cmp_eq_u32 vcc, s31, v66
  s_cmp_eq_u64 vcc, -1
  s_cbranch_scc1 L_fgot0
  s_sub_u32 s34, s34, 1
  s_cmp_lg_u32 s34, 0
  s_cbranch_scc1 L_fpoll
L_fgot0:
  v_lshlrev_b32 v4, 16, v64
  v_and_b32 v5, 0xffff0000, v64
  v_lshlrev_b32 v6, 16, v65
  v_and_b32 v7, 0xffff0000, v65
L_fsum:
  s_nop 0
  v_permlane32_swap_b32 v4, v5
  v_permlane32_swap_b32 v6, v7
  v_add_f32 v4, v4, v5
  v_add_f32 v6, v6, v7
  s_nop 1
  v_permlane16_swap_b32 v4, v6
  v_add_f32 v4, v4, v6
  s_nop 1
  v_add_f32_dpp v4, v4, v4 quad_perm:[2,3,0,1] row_mask:0xf bank_mask:0xf
  s_nop 1
  v_add_f32_dpp v4, v4, v4 row_ror:4 row_mask:0xf bank_mask:0xf
  s_nop 1
  v_add_f32_dpp v4, v4, v4 row_ror:8 row_mask:0xf bank_mask:0xf
  s_mov_b32 exec_lo, 0x00030003
  s_mov_b32 exec_hi, 0x00030003
  v_cvt_pk_bf16_f32 v4, v4, v4
  global_store_short v44, v4, s[14:15]
  s_cmp_lg_u32 s2, 0
  s_cbranch_scc1 L_noep
  s_mov_b64 exec, 1
  s_add_u32 s27, s32, 1
  v_mov_b32 v8, 0
  v_mov_b32 v9, s27
  global_store_dword v8, v9, s[18:19]
L_noep:
  s_mov_b64 exec, -1
L_fin:
L_end:
  s_endpgm
L_codeend:
.section .rodata,"a"
.p2align 6
.amdhsa_kernel standalone__sliding_block_cached__decode_kernel
  .amdhsa_next_free_vgpr 208
  .amdhsa_next_free_sgpr 102
  .amdhsa_accum_offset 208
  .amdhsa_group_segment_fixed_size 0
  .amdhsa_kernarg_size 64
  .amdhsa_user_sgpr_count 2
  .amdhsa_user_sgpr_kernarg_segment_ptr 1
  .amdhsa_system_sgpr_workgroup_id_x 1
  .amdhsa_float_denorm_mode_32 3
.end_amdhsa_kernel
```
